```python
import torch

def _softmax(x, axis=-1):
    return torch.softmax(x, dim=axis)
def _gelu(x):
    return torch.nn.functional.gelu(x, approximate="tanh")
def _silu(x):
    return torch.nn.functional.silu(x)
def _sigmoid(x):
    return torch.sigmoid(x)
def _layernorm(x, axis=-1, eps=1e-5):
    m = x.mean(dim=axis, keepdim=True)
    v = x.var(dim=axis, keepdim=True, unbiased=False)
    return (x - m) / torch.sqrt(v + eps)
def _scatter_add(tgt, idx, src, axis=0):
    return tgt.clone().index_add_(axis, idx, src)
def _segment_sum(src, seg, n):
    out = torch.zeros((n,) + src.shape[1:], dtype=src.dtype)
    return out.index_add_(0, seg, src)
def _pad(x, pw):
    flat = tuple(v for pair in reversed(pw) for v in pair)
    return torch.nn.functional.pad(x, flat)

kernel_name = 'parallel_sum__sliding_block_cached__glu_gated_geglu__decode'

def setup_inputs():

    _w = (lambda a: (lambda t: t.to(torch.bfloat16) if t.is_floating_point() else t)(torch.as_tensor(a)))
    def _A_setup():
        B, Sq, D = 4, 1, 512
        Hq, Hkv, Sk, Dh = 32, 8, 4096, 128
        assert Hq % Hkv == 0, (Hq, Hkv)
        return {
            "x": _w((lambda *s: torch.randn(*s, dtype=torch.bfloat16) * 0.05)(B, Sq, D)),
            "k_cache": _w((lambda *s: torch.randn(*s, dtype=torch.bfloat16) * 1.6)(B, Hkv, Sk, Dh)),
            "v_cache": _w((lambda *s: torch.randn(*s, dtype=torch.bfloat16) * 0.8)(B, Hkv, Sk, Dh)),
            "wq": _w((lambda *s: torch.randn(*s, dtype=torch.bfloat16) * 1.6)(D, Hq * Dh) * (D ** -0.5)),
            "wo": _w((lambda *s: torch.randn(*s, dtype=torch.bfloat16) * 0.8)(Hq * Dh, D) * ((Hq * Dh) ** -0.5)),
        }
    _A_in = _A_setup()

    def _B_setup():
        B, S, Dm, Df = 4, 1, 512, 1792
        return {
            "x": _w((lambda *s: torch.randn(*s, dtype=torch.bfloat16) * 0.05)(B, S, Dm)),
            "w_gate": _w((lambda *s: torch.randn(*s, dtype=torch.bfloat16) * 0.8)(Dm, Df) * (Dm ** -0.5)),
            "w_up": _w((lambda *s: torch.randn(*s, dtype=torch.bfloat16) * 0.8)(Dm, Df) * (Dm ** -0.5)),
            "w_down": _w((lambda *s: torch.randn(*s, dtype=torch.bfloat16) * 0.8)(Df, Dm) * (Df ** -0.5)),
        }
    _B_in = _B_setup()

    return {
        "A_x": _A_in["x"],
        "A_k_cache": _A_in["k_cache"],
        "A_v_cache": _A_in["v_cache"],
        "A_wq": _A_in["wq"],
        "A_wo": _A_in["wo"],
        "B_x": _B_in["x"],
        "B_w_gate": _B_in["w_gate"],
        "B_w_up": _B_in["w_up"],
        "B_w_down": _B_in["w_down"],
    }

def reference(A_x, A_k_cache, A_v_cache, A_wq, A_wo, B_x, B_w_gate, B_w_up, B_w_down):
    def _A_ref(x, k_cache, v_cache, wq, wo):
        B, Sq, D = x.shape
        Hq, Dh = 32, 128
        Hkv, Sk = k_cache.shape[1], k_cache.shape[2]
        W = min(4096, max(256, Sk // 4))
        rep = Hq // Hkv
        q = (lambda x, *d: x.permute(*d))((x @ wq).reshape(B, Sq, Hq, Dh), 0, 2, 1, 3)
        k = (lambda x, n, axis: torch.repeat_interleave(x, n, dim=axis))(k_cache[:, :, Sk - W:, :], rep, axis=1)
        v = (lambda x, n, axis: torch.repeat_interleave(x, n, dim=axis))(v_cache[:, :, Sk - W:, :], rep, axis=1)
        scores = torch.einsum("bhqd,bhkd->bhqk", q, k) * (Dh ** -0.5)
        p = _softmax(scores, axis=-1)
        o = torch.einsum("bhqk,bhkd->bhqd", p, v)
        return (lambda x, *d: x.permute(*d))(o, 0, 2, 1, 3).reshape(B, Sq, Hq * Dh) @ wo

    def _B_ref(x, w_gate, w_up, w_down):
        g = torch.einsum("bsd,df->bsf", x, w_gate)
        u = torch.einsum("bsd,df->bsf", x, w_up)
        h = _gelu(g) * u
        return torch.einsum("bsf,fd->bsd", h, w_down)

    x = A_x
    xn = _layernorm(x, axis=-1)
    return x + _A_ref(xn, A_k_cache, A_v_cache, A_wq, A_wo) + _B_ref(xn, B_w_gate, B_w_up, B_w_down)
```

```asm
; @launch grid=(256,1,1) block=(512,1,1) lds=33792
.amdgcn_target "amdgcn-amd-amdhsa--gfx950"
.text
.globl parallel_sum__sliding_block_cached__glu_gated_geglu__decode_kernel
.p2align 8
.type parallel_sum__sliding_block_cached__glu_gated_geglu__decode_kernel,@function
parallel_sum__sliding_block_cached__glu_gated_geglu__decode_kernel:
s_load_dwordx16 s[4:19], s[0:1], 0
s_load_dwordx8 s[20:27], s[0:1], 64
v_lshrrev_b32 v1, 6, v0
v_and_b32 v0, 63, v0
s_cmpk_gt_u32 s2, 255
s_cbranch_scc1 L_end
v_readfirstlane_b32 s3, v1
s_and_b32 s28, s2, 7
s_lshr_b32 s29, s2, 3
v_lshrrev_b32 v1, 3, v0
v_and_b32 v2, 6, v1
v_and_b32 v3, 7, v0
v_xor_b32 v2, v2, v3
s_cmp_lg_u32 s3, 4
s_cbranch_scc1 L_notq
v_and_b32 v3, 3, v1
v_lshrrev_b32 v4, 5, v0
v_lshl_add_u32 v3, v4, 3, v3
s_and_b32 s54, s29, 3
s_lshr_b32 s37, s29, 2
s_lshl_b32 s53, s28, 3
s_add_u32 s53, s53, s37
s_lshl_b32 s53, s53, 7
s_mov_b32 m0, 0
s_lshl_b32 s50, 1, 22
s_mov_b32 s51, 0x20000
v_lshlrev_b32 v79, 13, v3
v_lshl_add_u32 v79, v2, 4, v79
s_lshl_b32 s37, s54, 20
s_add_u32 s53, s53, s37
s_lshl_b32 s58, 1, 15
s_mul_i32 s59, s58, 3
s_movk_i32 s55, 16384
s_waitcnt lgkmcnt(0)
s_mov_b32 s48, s10
s_mov_b32 s49, s11
L_dma:
buffer_load_dwordx4 v79, s[48:51], s53 offen nt lds
s_addk_i32 m0, 2048
s_add_u32 s53, s53, s58
buffer_load_dwordx4 v79, s[48:51], s53 offen nt lds
s_addk_i32 m0, -1024
s_add_u32 s53, s53, s59
buffer_load_dwordx4 v79, s[48:51], s53 offen nt lds
s_addk_i32 m0, 2048
s_add_u32 s53, s53, s58
buffer_load_dwordx4 v79, s[48:51], s53 offen nt lds
s_addk_i32 m0, 1024
s_add_u32 s53, s53, s59
s_cmp_lt_u32 m0, s55
s_cbranch_scc1 L_dma
s_branch L_w_post
L_fe_end:
L_notq:
s_mov_b32 s56, 0
s_lshl_b32 s60, s28, 5
s_add_u32 s60, s60, s29
s_sub_u32 s60, s60, 32
s_cmp_lt_u32 s3, 4
s_cbranch_scc1 L_att
s_cmp_ge_u32 s3, 6
s_cbranch_scc1 L_w_idle
s_cmp_ge_u32 s60, 224
s_cbranch_scc1 L_w_idle
v_and_b32 v3, 3, v1
v_lshrrev_b32 v4, 5, v0
v_lshl_add_u32 v3, v4, 3, v3
s_bfe_u32 s54, s60, 0x20001
s_lshr_b32 s53, s60, 3
s_lshl_b32 s53, s53, 7
s_mul_i32 s37, s54, 458752
s_add_u32 s53, s53, s37
s_mov_b32 m0, 16384
s_mov_b32 s55, 32768
s_mov_b32 s50, 1835008
s_mov_b32 s51, 0x20000
v_mul_u32_u24 v79, 3584, v3
v_lshl_add_u32 v79, v2, 4, v79
s_movk_i32 s58, 14336
s_mov_b32 s59, 43008
s_bitcmp0_b32 s60, 0
s_waitcnt lgkmcnt(0)
s_cselect_b32 s48, s16, s18
s_cselect_b32 s49, s17, s19
s_branch L_dma
L_w_post:
s_lshl_b32 s60, s28, 5
s_add_u32 s60, s60, s29
s_sub_u32 s60, s60, 32
s_mov_b32 s56, 0
v_and_b32 v1, 3, v0
v_lshlrev_b32 v1, 10, v1
v_lshrrev_b32 v2, 4, v0
v_lshl_add_u32 v1, v2, 4, v1
v_bfe_u32 v3, v0, 2, 2
v_lshl_add_u32 v4, v3, 8, v1
s_lshl_b32 s37, s54, 8
v_add_u32 v1, s37, v1
s_mov_b32 exec_lo, 0x000f000f
s_mov_b32 exec_hi, 0x000f000f
global_load_dwordx4 v[24:27], v1, s[4:5] offset:0
global_load_dwordx4 v[28:31], v1, s[4:5] offset:64
global_load_dwordx4 v[32:35], v1, s[4:5] offset:128
global_load_dwordx4 v[36:39], v1, s[4:5] offset:192
s_mov_b64 exec, -1
global_load_dwordx4 v[8:11], v4, s[4:5] offset:0
global_load_dwordx4 v[12:15], v4, s[4:5] offset:64
global_load_dwordx4 v[16:19], v4, s[4:5] offset:128
global_load_dwordx4 v[20:23], v4, s[4:5] offset:192
s_load_dword s30, s[26:27], 0
s_barrier
L_w2:
s_cmp_eq_u32 s3, 4
s_cselect_b32 s39, 0, 16384
v_lshrrev_b32 v1, 2, v0
v_and_b32 v2, 6, v1
v_lshlrev_b32 v1, 7, v1
v_bfe_u32 v3, v0, 1, 1
v_lshl_add_u32 v1, v3, 4, v1
v_and_b32 v3, 1, v0
v_lshl_add_u32 v1, v3, 3, v1
v_add_u32 v1, s39, v1
v_xor_b32 v3, 0, v2
v_lshl_add_u32 v80, v3, 4, v1
v_xor_b32 v3, 2, v2
v_lshl_add_u32 v81, v3, 4, v1
v_xor_b32 v3, 4, v2
v_lshl_add_u32 v82, v3, 4, v1
v_xor_b32 v3, 6, v2
v_lshl_add_u32 v83, v3, 4, v1
v_mov_b32 v88, 0xffffff00
v_mov_b32 v72, 0x3f803f80
s_cbranch_scc0 L_w_gout
s_lshl_b32 s55, s28, 15
s_lshl_b32 s38, s54, 11
s_add_u32 s55, s55, s38
s_lshr_b32 s38, s29, 2
s_lshl_b32 s38, s38, 8
s_add_u32 s55, s55, s38
s_add_u32 s55, s55, 1114112
s_movk_i32 s42, 8192
s_branch L_w_oadr
L_w_gout:
s_and_b32 s37, s60, 1
s_lshl_b32 s38, s37, 4
s_add_u32 s38, s38, s54
s_mul_i32 s38, s38, 7168
s_lshr_b32 s55, s60, 3
s_lshl_b32 s55, s55, 8
s_add_u32 s55, s55, s38
s_add_u32 s55, s55, 2097152
s_movk_i32 s42, 28672
L_w_oadr:
v_and_b32 v1, 3, v0
v_mul_u32_u24 v92, s42, v1
v_bfe_u32 v1, v0, 2, 2
v_lshl_add_u32 v92, v1, 6, v92
v_lshrrev_b32 v1, 4, v0
v_lshl_add_u32 v92, v1, 4, v92
v_add_u32 v92, s55, v92
v_mov_b32 v73, 0
v_mov_b32 v74, 0
v_mov_b32 v77, 0
v_mov_b32 v78, 0
s_waitcnt lgkmcnt(0)
s_add_u32 s31, s30, 1
s_mul_i32 s31, s31, 0x9e3779b1
s_and_b32 s32, s31, 0xff
s_bfe_u32 s33, s31, 0x80008
s_bfe_u32 s34, s31, 0x80010
s_lshr_b32 s35, s31, 24
s_waitcnt vmcnt(20)
ds_read_b64_tr_b16 v[40:41], v80 offset:0
ds_read_b64_tr_b16 v[42:43], v80 offset:2048
ds_read_b64_tr_b16 v[44:45], v81 offset:0
ds_read_b64_tr_b16 v[46:47], v81 offset:2048
ds_read_b64_tr_b16 v[48:49], v82 offset:0
ds_read_b64_tr_b16 v[50:51], v82 offset:2048
ds_read_b64_tr_b16 v[52:53], v83 offset:0
ds_read_b64_tr_b16 v[54:55], v83 offset:2048
s_waitcnt vmcnt(4)
v_mov_b32_dpp v24, v72 quad_perm:[0,1,2,3] row_mask:0xf bank_mask:0x2
v_mov_b32_dpp v25, v72 quad_perm:[0,1,2,3] row_mask:0xf bank_mask:0x2
v_mov_b32_dpp v26, v72 quad_perm:[0,1,2,3] row_mask:0xf bank_mask:0x2
v_mov_b32_dpp v27, v72 quad_perm:[0,1,2,3] row_mask:0xf bank_mask:0x2
v_mov_b32_dpp v28, v72 quad_perm:[0,1,2,3] row_mask:0xf bank_mask:0x2
v_mov_b32_dpp v29, v72 quad_perm:[0,1,2,3] row_mask:0xf bank_mask:0x2
v_mov_b32_dpp v30, v72 quad_perm:[0,1,2,3] row_mask:0xf bank_mask:0x2
v_mov_b32_dpp v31, v72 quad_perm:[0,1,2,3] row_mask:0xf bank_mask:0x2
v_mov_b32_dpp v32, v72 quad_perm:[0,1,2,3] row_mask:0xf bank_mask:0x2
v_mov_b32_dpp v33, v72 quad_perm:[0,1,2,3] row_mask:0xf bank_mask:0x2
v_mov_b32_dpp v34, v72 quad_perm:[0,1,2,3] row_mask:0xf bank_mask:0x2
v_mov_b32_dpp v35, v72 quad_perm:[0,1,2,3] row_mask:0xf bank_mask:0x2
v_mov_b32_dpp v36, v72 quad_perm:[0,1,2,3] row_mask:0xf bank_mask:0x2
v_mov_b32_dpp v37, v72 quad_perm:[0,1,2,3] row_mask:0xf bank_mask:0x2
v_mov_b32_dpp v38, v72 quad_perm:[0,1,2,3] row_mask:0xf bank_mask:0x2
v_mov_b32_dpp v39, v72 quad_perm:[0,1,2,3] row_mask:0xf bank_mask:0x2
s_waitcnt lgkmcnt(6)
v_mfma_f32_16x16x32_bf16 v[56:59], v[40:43], v[24:27], 0
s_waitcnt lgkmcnt(4)
v_mfma_f32_16x16x32_bf16 v[60:63], v[44:47], v[24:27], 0
s_waitcnt lgkmcnt(2)
v_mfma_f32_16x16x32_bf16 v[64:67], v[48:51], v[24:27], 0
s_waitcnt lgkmcnt(0)
v_mfma_f32_16x16x32_bf16 v[68:71], v[52:55], v[24:27], 0
s_waitcnt vmcnt(16)
ds_read_b64_tr_b16 v[40:41], v80 offset:4096
ds_read_b64_tr_b16 v[42:43], v80 offset:6144
ds_read_b64_tr_b16 v[44:45], v81 offset:4096
ds_read_b64_tr_b16 v[46:47], v81 offset:6144
ds_read_b64_tr_b16 v[48:49], v82 offset:4096
ds_read_b64_tr_b16 v[50:51], v82 offset:6144
ds_read_b64_tr_b16 v[52:53], v83 offset:4096
ds_read_b64_tr_b16 v[54:55], v83 offset:6144
s_waitcnt vmcnt(0)
v_dot2c_f32_bf16 v73, v8, v72
v_dot2c_f32_bf16 v74, v8, v8
v_dot2c_f32_bf16 v77, v9, v72
v_dot2c_f32_bf16 v78, v9, v9
v_dot2c_f32_bf16 v73, v10, v72
v_dot2c_f32_bf16 v74, v10, v10
v_dot2c_f32_bf16 v77, v11, v72
v_dot2c_f32_bf16 v78, v11, v11
v_dot2c_f32_bf16 v73, v12, v72
v_dot2c_f32_bf16 v74, v12, v12
v_dot2c_f32_bf16 v77, v13, v72
v_dot2c_f32_bf16 v78, v13, v13
v_dot2c_f32_bf16 v73, v14, v72
v_dot2c_f32_bf16 v74, v14, v14
v_dot2c_f32_bf16 v77, v15, v72
v_dot2c_f32_bf16 v78, v15, v15
v_dot2c_f32_bf16 v73, v16, v72
v_dot2c_f32_bf16 v74, v16, v16
v_dot2c_f32_bf16 v77, v17, v72
v_dot2c_f32_bf16 v78, v17, v17
v_dot2c_f32_bf16 v73, v18, v72
v_dot2c_f32_bf16 v74, v18, v18
v_dot2c_f32_bf16 v77, v19, v72
v_dot2c_f32_bf16 v78, v19, v19
v_dot2c_f32_bf16 v73, v20, v72
v_dot2c_f32_bf16 v74, v20, v20
v_dot2c_f32_bf16 v77, v21, v72
v_dot2c_f32_bf16 v78, v21, v21
v_dot2c_f32_bf16 v73, v22, v72
v_dot2c_f32_bf16 v74, v22, v22
v_dot2c_f32_bf16 v77, v23, v72
v_dot2c_f32_bf16 v78, v23, v23
s_waitcnt lgkmcnt(6)
v_mfma_f32_16x16x32_bf16 v[56:59], v[40:43], v[28:31], v[56:59]
s_waitcnt lgkmcnt(4)
v_mfma_f32_16x16x32_bf16 v[60:63], v[44:47], v[28:31], v[60:63]
s_waitcnt lgkmcnt(2)
v_mfma_f32_16x16x32_bf16 v[64:67], v[48:51], v[28:31], v[64:67]
s_waitcnt lgkmcnt(0)
v_mfma_f32_16x16x32_bf16 v[68:71], v[52:55], v[28:31], v[68:71]
s_waitcnt vmcnt(12)
ds_read_b64_tr_b16 v[40:41], v80 offset:8192
ds_read_b64_tr_b16 v[42:43], v80 offset:10240
ds_read_b64_tr_b16 v[44:45], v81 offset:8192
ds_read_b64_tr_b16 v[46:47], v81 offset:10240
ds_read_b64_tr_b16 v[48:49], v82 offset:8192
ds_read_b64_tr_b16 v[50:51], v82 offset:10240
ds_read_b64_tr_b16 v[52:53], v83 offset:8192
ds_read_b64_tr_b16 v[54:55], v83 offset:10240
v_add_f32 v73, v73, v77
v_add_f32 v74, v74, v78
s_nop 0
v_add_f32_dpp v73, v73, v73 row_ror:4 row_mask:0xf bank_mask:0xf
v_add_f32_dpp v74, v74, v74 row_ror:4 row_mask:0xf bank_mask:0xf
s_nop 0
v_add_f32_dpp v73, v73, v73 row_ror:8 row_mask:0xf bank_mask:0xf
v_add_f32_dpp v74, v74, v74 row_ror:8 row_mask:0xf bank_mask:0xf
v_mov_b32 v1, v73
v_mov_b32 v2, v74
s_nop 0
v_permlane16_swap_b32 v1, v73
v_permlane16_swap_b32 v2, v74
v_add_f32 v73, v73, v1
v_add_f32 v74, v74, v2
v_mov_b32 v1, v73
v_mov_b32 v2, v74
s_nop 0
v_permlane32_swap_b32 v1, v73
v_permlane32_swap_b32 v2, v74
v_add_f32 v73, v73, v1
v_add_f32 v74, v74, v2
s_waitcnt lgkmcnt(6)
v_mfma_f32_16x16x32_bf16 v[56:59], v[40:43], v[32:35], v[56:59]
s_waitcnt lgkmcnt(4)
v_mfma_f32_16x16x32_bf16 v[60:63], v[44:47], v[32:35], v[60:63]
s_waitcnt lgkmcnt(2)
v_mfma_f32_16x16x32_bf16 v[64:67], v[48:51], v[32:35], v[64:67]
s_waitcnt lgkmcnt(0)
v_mfma_f32_16x16x32_bf16 v[68:71], v[52:55], v[32:35], v[68:71]
s_waitcnt vmcnt(8)
ds_read_b64_tr_b16 v[40:41], v80 offset:12288
ds_read_b64_tr_b16 v[42:43], v80 offset:14336
ds_read_b64_tr_b16 v[44:45], v81 offset:12288
ds_read_b64_tr_b16 v[46:47], v81 offset:14336
ds_read_b64_tr_b16 v[48:49], v82 offset:12288
ds_read_b64_tr_b16 v[50:51], v82 offset:14336
ds_read_b64_tr_b16 v[52:53], v83 offset:12288
ds_read_b64_tr_b16 v[54:55], v83 offset:14336
v_mul_f32 v73, 0x3b000000, v73
v_mul_f32 v74, 0x3b000000, v74
v_fma_f32 v74, -v73, v73, v74
v_max_f32 v74, 0, v74
v_cvt_pk_bf16_f32 v75, v73, v73
v_lshlrev_b32 v75, 16, v75
v_xor_b32 v75, 0x80000000, v75
v_cvt_pk_bf16_f32 v74, v74, v74
v_lshlrev_b32 v74, 16, v74
v_add_f32 v74, 0x3727c5ac, v74
v_cvt_pk_bf16_f32 v74, v74, v74
v_lshlrev_b32 v74, 16, v74
v_sqrt_f32 v74, v74
s_nop 0
v_cvt_pk_bf16_f32 v74, v74, v74
v_lshlrev_b32 v74, 16, v74
v_rcp_f32 v76, v74
s_waitcnt lgkmcnt(6)
v_mfma_f32_16x16x32_bf16 v[56:59], v[40:43], v[36:39], v[56:59]
s_waitcnt lgkmcnt(4)
v_mfma_f32_16x16x32_bf16 v[60:63], v[44:47], v[36:39], v[60:63]
s_waitcnt lgkmcnt(2)
v_mfma_f32_16x16x32_bf16 v[64:67], v[48:51], v[36:39], v[64:67]
s_waitcnt lgkmcnt(0)
v_mfma_f32_16x16x32_bf16 v[68:71], v[52:55], v[36:39], v[68:71]
s_nop 4
v_fmac_f32_dpp v56, v56, v75 row_shl:4 row_mask:0xf bank_mask:0x1
v_fmac_f32_dpp v57, v57, v75 row_shl:4 row_mask:0xf bank_mask:0x1
v_fmac_f32_dpp v58, v58, v75 row_shl:4 row_mask:0xf bank_mask:0x1
v_fmac_f32_dpp v59, v59, v75 row_shl:4 row_mask:0xf bank_mask:0x1
v_fmac_f32_dpp v60, v60, v75 row_shl:4 row_mask:0xf bank_mask:0x1
v_fmac_f32_dpp v61, v61, v75 row_shl:4 row_mask:0xf bank_mask:0x1
v_fmac_f32_dpp v62, v62, v75 row_shl:4 row_mask:0xf bank_mask:0x1
v_fmac_f32_dpp v63, v63, v75 row_shl:4 row_mask:0xf bank_mask:0x1
v_fmac_f32_dpp v64, v64, v75 row_shl:4 row_mask:0xf bank_mask:0x1
v_fmac_f32_dpp v65, v65, v75 row_shl:4 row_mask:0xf bank_mask:0x1
v_fmac_f32_dpp v66, v66, v75 row_shl:4 row_mask:0xf bank_mask:0x1
v_fmac_f32_dpp v67, v67, v75 row_shl:4 row_mask:0xf bank_mask:0x1
v_fmac_f32_dpp v68, v68, v75 row_shl:4 row_mask:0xf bank_mask:0x1
v_fmac_f32_dpp v69, v69, v75 row_shl:4 row_mask:0xf bank_mask:0x1
v_fmac_f32_dpp v70, v70, v75 row_shl:4 row_mask:0xf bank_mask:0x1
v_fmac_f32_dpp v71, v71, v75 row_shl:4 row_mask:0xf bank_mask:0x1
v_mov_b32_dpp v84, v56 quad_perm:[0,1,2,3] row_mask:0xf bank_mask:0x1
v_mov_b32_dpp v85, v57 quad_perm:[0,1,2,3] row_mask:0xf bank_mask:0x1
v_mov_b32_dpp v86, v58 quad_perm:[0,1,2,3] row_mask:0xf bank_mask:0x1
v_mov_b32_dpp v87, v59 quad_perm:[0,1,2,3] row_mask:0xf bank_mask:0x1
v_mov_b32_dpp v84, v60 row_shr:4 row_mask:0xf bank_mask:0x2
v_mov_b32_dpp v85, v61 row_shr:4 row_mask:0xf bank_mask:0x2
v_mov_b32_dpp v86, v62 row_shr:4 row_mask:0xf bank_mask:0x2
v_mov_b32_dpp v87, v63 row_shr:4 row_mask:0xf bank_mask:0x2
v_mov_b32_dpp v84, v64 row_shr:8 row_mask:0xf bank_mask:0x4
v_mov_b32_dpp v85, v65 row_shr:8 row_mask:0xf bank_mask:0x4
v_mov_b32_dpp v86, v66 row_shr:8 row_mask:0xf bank_mask:0x4
v_mov_b32_dpp v87, v67 row_shr:8 row_mask:0xf bank_mask:0x4
v_mov_b32_dpp v84, v68 row_shr:12 row_mask:0xf bank_mask:0x8
v_mov_b32_dpp v85, v69 row_shr:12 row_mask:0xf bank_mask:0x8
v_mov_b32_dpp v86, v70 row_shr:12 row_mask:0xf bank_mask:0x8
v_mov_b32_dpp v87, v71 row_shr:12 row_mask:0xf bank_mask:0x8
v_mul_f32 v84, v84, v76
v_mul_f32 v85, v85, v76
v_mul_f32 v86, v86, v76
v_mul_f32 v87, v87, v76
v_and_or_b32 v84, v84, v88, s32
v_and_or_b32 v85, v85, v88, s33
v_and_or_b32 v86, v86, v88, s34
v_and_or_b32 v87, v87, v88, s35
s_cmp_eq_u32 s3, 4
s_cbranch_scc0 L_w_nodual
v_subrev_u32 v1, 1048576, v92
global_store_dwordx4 v1, v[84:87], s[26:27]
L_w_nodual:
global_store_dwordx4 v92, v[84:87], s[26:27] sc1
L_w_b1:
s_sub_u32 s57, s3, 4
s_lshr_b32 s36, s29, 3
s_lshl_b32 s37, s28, 2
s_add_u32 s37, s37, s36
s_lshl_b32 s37, s37, 7
s_lshl_b32 s38, s57, 5
s_add_u32 s37, s37, s38
s_bfe_u32 s38, s29, 0x10002
s_lshl_b32 s39, s38, 2
s_add_u32 s37, s37, s39
s_lshl_b32 s37, s37, 10
s_and_b32 s39, s29, 3
s_lshl_b32 s39, s39, 8
s_add_u32 s37, s37, s39
s_add_u32 s12, s12, s37
s_addc_u32 s13, s13, 0
v_lshrrev_b32 v1, 4, v0
v_and_b32 v2, 15, v0
v_lshlrev_b32 v2, 4, v2
v_lshl_add_u32 v48, v1, 10, v2
v_lshl_add_u32 v49, v1, 11, v2
s_lshr_b32 s37, s60, 2
s_lshl_b32 s37, s37, 5
s_lshl_b32 s42, s57, 3
s_add_u32 s37, s37, s42
s_lshl_b32 s42, s37, 10
s_add_u32 s42, s42, s39
s_add_u32 s20, s20, s42
s_addc_u32 s21, s21, 0
s_lshl_b32 s37, s37, 2
s_add_u32 s37, s37, 2097152
s_add_u32 s44, s26, s37
s_addc_u32 s45, s27, 0
v_and_b32 v3, 3, v0
v_bfe_u32 v4, v0, 2, 2
v_lshl_add_u32 v50, v3, 2, v4
v_mul_u32_u24 v50, 7168, v50
v_lshrrev_b32 v2, 5, v0
v_lshl_add_u32 v50, v2, 4, v50
v_add_u32 v76, 114688, v50
v_lshlrev_b32 v53, 17, v3
v_lshl_add_u32 v53, v4, 14, v53
v_lshl_add_u32 v53, v1, 6, v53
s_lshl_b32 s37, s28, 11
s_lshl_b32 s42, s38, 10
s_add_u32 s37, s37, s42
s_lshl_b32 s42, s57, 8
s_add_u32 s37, s37, s42
s_lshl_b32 s42, s36, 4
s_add_u32 s37, s37, s42
s_add_u32 s37, s37, 1572864
s_add_u32 s46, s26, s37
s_addc_u32 s47, s27, 0
s_lshl_b32 s37, s28, 16
s_lshl_b32 s42, s36, 14
s_add_u32 s37, s37, s42
s_lshl_b32 s42, s38, 13
s_add_u32 s37, s37, s42
s_lshl_b32 s42, s57, 11
s_add_u32 s37, s37, s42
s_add_u32 s37, s37, 524288
s_add_u32 s40, s26, s37
s_addc_u32 s41, s27, 0
v_lshlrev_b32 v51, 4, v0
v_add_u32 v52, 1024, v51
s_lshl_b32 s37, s57, 11
v_add_u32 v78, s37, v51
s_lshl_b32 s37, s28, 5
s_add_u32 s37, s37, s29
s_lshl_b32 s37, s37, 11
s_lshl_b32 s42, s57, 10
s_add_u32 s37, s37, s42
s_add_u32 s37, s37, 2621440
v_add_u32 v79, s37, v51
v_mov_b32 v77, 0xffffff00
v_and_b32 v1, 1, v4
v_lshlrev_b32 v1, 4, v1
v_mov_b32 v2, 0xffff
v_lshlrev_b32 v2, v1, v2
v_cmp_gt_u32 vcc, 2, v4
v_mov_b32 v1, 0
s_mov_b32 s56, 0
v_mov_b32 v68, 0
v_cndmask_b32 v54, v1, v2, vcc
v_cndmask_b32 v55, v2, v1, vcc
v_mov_b32 v72, 0
v_mov_b32 v69, 0
v_mov_b32 v73, 0
v_mov_b32 v70, 0
v_mov_b32 v74, 0
v_mov_b32 v71, 0
v_mov_b32 v75, 0
s_barrier
s_cmp_ge_u32 s60, 224
s_cbranch_scc1 L_c_noffn_ld
global_load_dwordx4 v[32:35], v50, s[44:45] sc1
global_load_dwordx4 v[36:39], v76, s[44:45] sc1
global_load_dwordx4 v[24:27], v49, s[20:21] offset:0 nt
global_load_dwordx4 v[28:31], v49, s[20:21] offset:1024 nt
L_c_noffn_ld:
global_load_dwordx4 v[8:11], v48, s[12:13] nt
v_add_u32 v1, 8192, v48
global_load_dwordx4 v[12:15], v1, s[12:13] nt
v_add_u32 v1, 16384, v48
global_load_dwordx4 v[16:19], v1, s[12:13] nt
v_add_u32 v1, 24576, v48
global_load_dwordx4 v[20:23], v1, s[12:13] nt
s_barrier
s_cmp_ge_u32 s60, 224
s_cbranch_scc1 L_c_noffn
s_waitcnt vmcnt(4)
L_h_chk:
v_xor_b32 v32, s32, v32
v_xor_b32 v33, s33, v33
v_xor_b32 v34, s34, v34
v_xor_b32 v35, s35, v35
v_xor_b32 v36, s32, v36
v_xor_b32 v37, s33, v37
v_xor_b32 v38, s34, v38
v_xor_b32 v39, s35, v39
v_or3_b32 v1, v32, v33, v34
v_or3_b32 v1, v1, v35, v36
v_or3_b32 v1, v1, v37, v38
v_or_b32 v1, v1, v39
v_and_b32 v1, 0xff, v1
v_cmp_ne_u32 vcc, 0, v1
s_cbranch_vccz L_h_ok
s_add_u32 s56, s56, 1
s_cmp_gt_u32 s56, 60000
s_cbranch_scc1 L_h_ok
global_load_dwordx4 v[32:35], v50, s[44:45] sc1
global_load_dwordx4 v[36:39], v76, s[44:45] sc1
s_waitcnt vmcnt(0)
s_branch L_h_chk
L_h_ok:
L_dry5_in:
v_bfe_u32 v1, v0, 4, 1
v_cmp_eq_u32 vcc, 1, v1
s_nop 1
v_cndmask_b32 v32, v32, v34, vcc
v_cndmask_b32 v33, v33, v35, vcc
v_cndmask_b32 v36, v36, v38, vcc
v_cndmask_b32 v37, v37, v39, vcc
v_add_f32_dpp v32, v32, v32 row_ror:4 row_mask:0xf bank_mask:0xf
v_add_f32_dpp v33, v33, v33 row_ror:4 row_mask:0xf bank_mask:0xf
v_add_f32_dpp v36, v36, v36 row_ror:4 row_mask:0xf bank_mask:0xf
v_add_f32_dpp v37, v37, v37 row_ror:4 row_mask:0xf bank_mask:0xf
v_add_f32_dpp v32, v32, v32 row_ror:8 row_mask:0xf bank_mask:0xf
v_add_f32_dpp v33, v33, v33 row_ror:8 row_mask:0xf bank_mask:0xf
v_add_f32_dpp v36, v36, v36 row_ror:8 row_mask:0xf bank_mask:0xf
v_add_f32_dpp v37, v37, v37 row_ror:8 row_mask:0xf bank_mask:0xf
v_mov_b32 v3, 0x3d372713
v_mul_f32 v34, v32, v32
v_mul_f32 v35, v33, v33
v_fma_f32 v34, v34, v3, 1.0
v_fma_f32 v35, v35, v3, 1.0
v_mul_f32 v34, v34, v32
v_mul_f32 v35, v35, v33
v_mul_f32 v34, 0xc0135761, v34
v_mul_f32 v35, 0xc0135761, v35
v_exp_f32 v34, v34
v_exp_f32 v35, v35
s_nop 0
v_add_f32 v34, 1.0, v34
v_add_f32 v35, 1.0, v35
v_rcp_f32 v34, v34
v_rcp_f32 v35, v35
s_nop 0
v_mul_f32 v32, v32, v34
v_mul_f32 v33, v33, v35
v_mul_f32 v32, v32, v36
v_mul_f32 v33, v33, v37
v_cvt_pk_bf16_f32 v32, v32, v32
v_cvt_pk_bf16_f32 v33, v33, v33
v_and_b32 v64, v32, v54
v_and_b32 v65, v32, v55
v_and_b32 v66, v33, v54
v_and_b32 v67, v33, v55
s_nop 0
v_mfma_f32_16x16x16_bf16 v[68:71], v[24:25], v[64:65], v[68:71]
v_mfma_f32_16x16x16_bf16 v[72:75], v[26:27], v[64:65], v[72:75]
v_mfma_f32_16x16x16_bf16 v[68:71], v[28:29], v[66:67], v[68:71]
v_mfma_f32_16x16x16_bf16 v[72:75], v[30:31], v[66:67], v[72:75]
s_cbranch_execz L_dry5_out
s_mov_b32 s56, 0
L_c_noffn:
s_waitcnt vmcnt(2)
global_load_dwordx4 v[40:43], v51, s[40:41] sc1
global_load_dwordx4 v[44:47], v52, s[40:41] sc1
s_waitcnt vmcnt(0)
L_p_chk:
v_cmp_ne_u32 vcc, s31, v43
v_cmp_ne_u32 s[42:43], s31, v47
s_or_b64 vcc, vcc, s[42:43]
s_cbranch_vccz L_p_ok
s_add_u32 s56, s56, 1
s_cmp_lg_u32 s56, 40
s_cbranch_scc1 L_p_nosw
s_mov_b32 s40, s46
s_mov_b32 s41, s47
v_mov_b32 v51, v53
v_add_u32 v52, 0x10000, v53
L_p_nosw:
s_cmp_gt_u32 s56, 60000
s_cbranch_scc1 L_p_ok
global_load_dwordx4 v[40:43], v51, s[40:41] sc1
global_load_dwordx4 v[44:47], v52, s[40:41] sc1
s_waitcnt vmcnt(0)
s_branch L_p_chk
L_p_ok:
L_dry2_in:
v_max_f32 v56, v42, v46
v_lshlrev_b32 v60, 16, v40
v_and_b32 v61, 0xffff0000, v40
v_max_f32_dpp v56, v56, v56 row_ror:4 row_mask:0xf bank_mask:0xf
v_lshlrev_b32 v62, 16, v41
v_and_b32 v63, 0xffff0000, v41
v_max_f32_dpp v56, v56, v56 row_ror:8 row_mask:0xf bank_mask:0xf
v_lshlrev_b32 v40, 16, v44
v_and_b32 v41, 0xffff0000, v44
v_sub_f32 v57, v42, v56
v_sub_f32 v58, v46, v56
v_exp_f32 v57, v57
v_exp_f32 v58, v58
v_lshlrev_b32 v42, 16, v45
v_and_b32 v43, 0xffff0000, v45
v_add_f32 v59, v57, v58
v_mul_f32 v60, v60, v57
v_mul_f32 v61, v61, v57
v_mul_f32 v62, v62, v57
v_mul_f32 v63, v63, v57
v_fmac_f32 v60, v40, v58
v_fmac_f32 v61, v41, v58
v_fmac_f32 v62, v42, v58
v_fmac_f32 v63, v43, v58
v_add_f32_dpp v59, v59, v59 row_ror:4 row_mask:0xf bank_mask:0xf
v_add_f32_dpp v60, v60, v60 row_ror:4 row_mask:0xf bank_mask:0xf
v_add_f32_dpp v61, v61, v61 row_ror:4 row_mask:0xf bank_mask:0xf
v_add_f32_dpp v62, v62, v62 row_ror:4 row_mask:0xf bank_mask:0xf
v_add_f32_dpp v63, v63, v63 row_ror:4 row_mask:0xf bank_mask:0xf
v_add_f32_dpp v59, v59, v59 row_ror:8 row_mask:0xf bank_mask:0xf
v_add_f32_dpp v60, v60, v60 row_ror:8 row_mask:0xf bank_mask:0xf
v_add_f32_dpp v61, v61, v61 row_ror:8 row_mask:0xf bank_mask:0xf
v_add_f32_dpp v62, v62, v62 row_ror:8 row_mask:0xf bank_mask:0xf
v_add_f32_dpp v63, v63, v63 row_ror:8 row_mask:0xf bank_mask:0xf
v_rcp_f32 v59, v59
s_nop 0
v_mul_f32 v60, v60, v59
v_mul_f32 v61, v61, v59
v_mul_f32 v62, v62, v59
v_mul_f32 v63, v63, v59
v_cvt_pk_bf16_f32 v60, v60, v60
v_cvt_pk_bf16_f32 v61, v61, v61
v_cvt_pk_bf16_f32 v62, v62, v62
v_cvt_pk_bf16_f32 v63, v63, v63
v_and_b32 v40, v60, v54
v_and_b32 v41, v60, v55
v_and_b32 v42, v61, v54
v_and_b32 v43, v61, v55
v_and_b32 v44, v62, v54
v_and_b32 v45, v62, v55
v_and_b32 v46, v63, v54
v_and_b32 v47, v63, v55
s_nop 0
v_mfma_f32_16x16x16_bf16 v[68:71], v[8:9], v[40:41], v[68:71]
v_mfma_f32_16x16x16_bf16 v[72:75], v[10:11], v[40:41], v[72:75]
v_mfma_f32_16x16x16_bf16 v[68:71], v[12:13], v[42:43], v[68:71]
v_mfma_f32_16x16x16_bf16 v[72:75], v[14:15], v[42:43], v[72:75]
v_mfma_f32_16x16x16_bf16 v[68:71], v[16:17], v[44:45], v[68:71]
v_mfma_f32_16x16x16_bf16 v[72:75], v[18:19], v[44:45], v[72:75]
v_mfma_f32_16x16x16_bf16 v[68:71], v[20:21], v[46:47], v[68:71]
v_mfma_f32_16x16x16_bf16 v[72:75], v[22:23], v[46:47], v[72:75]
s_cbranch_execz L_dry2_out
s_nop 5
ds_write_b128 v78, v[68:71] offset:16384
ds_write_b128 v78, v[72:75] offset:17408
s_lshl_b32 s38, s57, 10
v_lshlrev_b32 v1, 4, v0
v_add_u32 v2, s38, v1
s_waitcnt lgkmcnt(0)
s_barrier
s_cmp_ge_u32 s57, 2
s_cbranch_scc1 L_fin
ds_read_b128 v[8:11], v2 offset:16384
ds_read_b128 v[12:15], v2 offset:18432
ds_read_b128 v[16:19], v2 offset:20480
ds_read_b128 v[20:23], v2 offset:22528
s_waitcnt lgkmcnt(2)
L_dry3_in:
v_add_f32 v8, v8, v12
v_add_f32 v9, v9, v13
v_add_f32 v10, v10, v14
v_add_f32 v11, v11, v15
s_waitcnt lgkmcnt(0)
v_add_f32 v16, v16, v20
v_add_f32 v17, v17, v21
v_add_f32 v18, v18, v22
v_add_f32 v19, v19, v23
v_add_f32 v8, v8, v16
v_add_f32 v9, v9, v17
v_add_f32 v10, v10, v18
v_add_f32 v11, v11, v19
v_and_or_b32 v8, v8, v77, s32
v_and_or_b32 v9, v9, v77, s33
v_and_or_b32 v10, v10, v77, s34
v_and_or_b32 v11, v11, v77, s35
s_cbranch_execz L_dry3_out
global_store_dwordx4 v79, v[8:11], s[26:27] sc1
s_branch L_fin
L_w_idle:
s_cmp_lg_u32 s3, 7
s_cbranch_scc1 L_nocpf
s_and_b32 s36, s29, 7
s_cmp_lg_u32 s36, 0
s_cbranch_scc1 L_nocpf
s_getpc_b64 s[42:43]
L_pcref:
s_sub_u32 s42, s42, L_pcref-parallel_sum__sliding_block_cached__glu_gated_geglu__decode_kernel
s_subb_u32 s43, s43, 0
v_lshlrev_b32 v1, 4, v0
s_mov_b32 s36, L_code_end-parallel_sum__sliding_block_cached__glu_gated_geglu__decode_kernel-16
v_min_u32 v2, s36, v1
global_load_dwordx4 v[8:11], v2, s[42:43]
v_add_u32 v1, 0x400, v1
v_min_u32 v2, s36, v1
global_load_dwordx4 v[8:11], v2, s[42:43]
v_add_u32 v1, 0x400, v1
v_min_u32 v2, s36, v1
global_load_dwordx4 v[8:11], v2, s[42:43]
v_add_u32 v1, 0x400, v1
v_min_u32 v2, s36, v1
global_load_dwordx4 v[8:11], v2, s[42:43]
v_add_u32 v1, 0x400, v1
v_min_u32 v2, s36, v1
global_load_dwordx4 v[8:11], v2, s[42:43]
v_add_u32 v1, 0x400, v1
v_min_u32 v2, s36, v1
global_load_dwordx4 v[8:11], v2, s[42:43]
v_add_u32 v1, 0x400, v1
v_min_u32 v2, s36, v1
global_load_dwordx4 v[8:11], v2, s[42:43]
v_add_u32 v1, 0x400, v1
L_nocpf:
s_waitcnt lgkmcnt(0)
s_load_dword s30, s[26:27], 0
s_barrier
s_waitcnt lgkmcnt(0)
s_add_u32 s31, s30, 1
s_mul_i32 s31, s31, 0x9e3779b1
s_and_b32 s32, s31, 0xff
s_bfe_u32 s33, s31, 0x80008
s_bfe_u32 s34, s31, 0x80010
s_lshr_b32 s35, s31, 24
s_cmp_lg_u32 s3, 6
s_cbranch_scc1 L_dry_done
s_mov_b64 exec, 0
s_branch L_dry6_in
L_dry6_out:
s_branch L_dry0_in
L_dry0_out:
s_branch L_dry1_in
L_dry1_out:
s_branch L_dry5_in
L_dry5_out:
s_branch L_dry2_in
L_dry2_out:
s_branch L_dry3_in
L_dry3_out:
s_branch L_dry4_in
L_dry4_out:
s_mov_b64 exec, -1
L_dry_done:
s_branch L_w_b1
L_att:
s_lshr_b32 s36, s29, 3
s_lshl_b32 s37, s36, 23
s_lshl_b32 s38, s28, 20
s_add_u32 s37, s37, s38
s_and_b32 s38, s29, 7
s_lshl_b32 s38, s38, 15
s_add_u32 s37, s37, s38
s_lshl_b32 s38, s3, 13
s_add_u32 s37, s37, s38
s_add_u32 s37, s37, 0xc1000
v_and_b32 v1, 12, v0
v_lshlrev_b32 v1, 6, v1
v_lshrrev_b32 v2, 4, v0
v_lshl_add_u32 v1, v2, 6, v1
v_and_b32 v3, 3, v0
v_lshl_add_u32 v5, v3, 4, v1
v_lshlrev_b32 v6, 4, v0
v_lshlrev_b32 v7, 9, v3
v_lshl_add_u32 v7, v2, 11, v7
v_bfe_u32 v4, v0, 2, 2
v_lshl_add_u32 v7, v4, 5, v7
s_lshl_b32 s38, s28, 2
s_add_u32 s38, s38, s36
s_lshl_b32 s38, s38, 13
s_lshl_b32 s39, s3, 7
s_add_u32 s38, s38, s39
s_add_u32 s38, s38, 65536
s_waitcnt lgkmcnt(0)
s_add_u32 s6, s6, s37
s_addc_u32 s7, s7, 0
s_add_u32 s8, s8, s37
s_addc_u32 s9, s9, 0
s_add_u32 s40, s26, s38
s_addc_u32 s41, s27, 0
s_load_dword s30, s[26:27], 0
s_barrier
global_load_dwordx4 v[8:11], v5, s[6:7] offset:-4096 nt
global_load_dwordx4 v[12:15], v5, s[6:7] offset:-3072 nt
global_load_dwordx4 v[16:19], v5, s[6:7] offset:-2048 nt
global_load_dwordx4 v[20:23], v5, s[6:7] offset:-1024 nt
v_mov_b32 v117, 0x3e0293ee
v_mov_b32 v122, 0
v_mov_b32 v123, 0
v_mov_b32 v124, 0
v_mov_b32 v125, 0
v_and_b32 v1, 15, v0
v_lshlrev_b32 v1, 4, v1
v_lshl_add_u32 v1, v2, 2, v1
s_lshl_b32 s39, s3, 8
v_add_u32 v4, s39, v1
s_waitcnt lgkmcnt(0)
s_add_u32 s31, s30, 1
s_mul_i32 s31, s31, 0x9e3779b1
s_and_b32 s32, s31, 0xff
s_bfe_u32 s33, s31, 0x80008
s_bfe_u32 s34, s31, 0x80010
s_lshr_b32 s35, s31, 24
s_waitcnt vmcnt(3)
global_load_dwordx4 v[24:27], v5, s[6:7] offset:0 nt
s_waitcnt vmcnt(3)
global_load_dwordx4 v[28:31], v5, s[6:7] offset:1024 nt
s_waitcnt vmcnt(3)
global_load_dwordx4 v[32:35], v5, s[6:7] offset:2048 nt
s_waitcnt vmcnt(3)
global_load_dwordx4 v[36:39], v5, s[6:7] offset:3072 nt
s_waitcnt vmcnt(3)
global_load_dwordx4 v[40:43], v6, s[8:9] offset:-4096 nt
s_waitcnt vmcnt(3)
global_load_dwordx4 v[44:47], v6, s[8:9] offset:-3072 nt
s_waitcnt vmcnt(3)
global_load_dwordx4 v[48:51], v6, s[8:9] offset:-2048 nt
s_waitcnt vmcnt(3)
global_load_dwordx4 v[72:75], v7, s[40:41] sc1
global_load_dwordx4 v[76:79], v7, s[40:41] offset:16 sc1
s_waitcnt vmcnt(5)
global_load_dwordx4 v[52:55], v6, s[8:9] offset:-1024 nt
s_waitcnt vmcnt(5)
global_load_dwordx4 v[56:59], v6, s[8:9] offset:0 nt
s_waitcnt vmcnt(2)
L_q_chk:
v_xor_b32 v72, s32, v72
v_xor_b32 v73, s33, v73
v_xor_b32 v74, s34, v74
v_xor_b32 v75, s35, v75
v_xor_b32 v76, s32, v76
v_xor_b32 v77, s33, v77
v_xor_b32 v78, s34, v78
v_xor_b32 v79, s35, v79
v_or3_b32 v1, v72, v73, v74
v_or3_b32 v1, v1, v75, v76
v_or3_b32 v1, v1, v77, v78
v_or_b32 v1, v1, v79
v_and_b32 v1, 0xff, v1
v_cmp_ne_u32 vcc, 0, v1
s_cbranch_vccz L_q_ok
s_add_u32 s56, s56, 1
s_cmp_lg_u32 s56, 40
s_cbranch_scc1 L_q_nosw
s_add_u32 s40, s40, 1048576
s_addc_u32 s41, s41, 0
L_q_nosw:
s_cmp_gt_u32 s56, 60000
s_cbranch_scc1 L_q_ok
global_load_dwordx4 v[72:75], v7, s[40:41] sc1
global_load_dwordx4 v[76:79], v7, s[40:41] offset:16 sc1
s_waitcnt vmcnt(0)
s_branch L_q_chk
L_q_ok:
L_dry6_in:
v_permlane32_swap_b32 v72, v76
v_permlane32_swap_b32 v74, v78
v_permlane32_swap_b32 v73, v77
v_permlane32_swap_b32 v75, v79
v_add_f32 v72, v72, v76
v_add_f32 v73, v73, v77
v_add_f32 v74, v74, v78
v_add_f32 v75, v75, v79
s_nop 0
v_permlane16_swap_b32 v72, v74
v_permlane16_swap_b32 v73, v75
v_add_f32 v72, v72, v74
v_add_f32 v73, v73, v75
v_cvt_pk_bf16_f32 v72, v72, v73
s_cbranch_execz L_dry6_out
ds_write_b32 v4, v72 offset:32768
global_load_dwordx4 v[60:63], v6, s[8:9] offset:1024 nt
global_load_dwordx4 v[64:67], v6, s[8:9] offset:2048 nt
global_load_dwordx4 v[68:71], v6, s[8:9] offset:3072 nt
v_lshlrev_b32 v1, 4, v0
s_waitcnt lgkmcnt(0)
s_barrier
ds_read_b128 v[72:75], v1 offset:32768
s_waitcnt vmcnt(10)
s_waitcnt lgkmcnt(0)
L_dry0_in:
v_mfma_f32_16x16x32_bf16 v[80:83], v[8:11], v[72:75], 0
v_mfma_f32_16x16x32_bf16 v[84:87], v[12:15], v[72:75], 0
v_mfma_f32_16x16x32_bf16 v[88:91], v[16:19], v[72:75], 0
v_mfma_f32_16x16x32_bf16 v[92:95], v[20:23], v[72:75], 0
v_mfma_f32_16x16x32_bf16 v[96:99], v[24:27], v[72:75], 0
v_mfma_f32_16x16x32_bf16 v[100:103], v[28:31], v[72:75], 0
v_mfma_f32_16x16x32_bf16 v[104:107], v[32:35], v[72:75], 0
v_mfma_f32_16x16x32_bf16 v[108:111], v[36:39], v[72:75], 0
s_nop 1
v_mov_b32_dpp v112, v80 quad_perm:[0,1,2,3] row_mask:0xf bank_mask:0x1
v_add_f32_dpp v112, v81, v112 row_ror:12 row_mask:0xf bank_mask:0x1
v_add_f32_dpp v112, v82, v112 row_ror:8 row_mask:0xf bank_mask:0x1
v_add_f32_dpp v112, v83, v112 row_ror:4 row_mask:0xf bank_mask:0x1
v_mov_b32_dpp v112, v84 row_ror:4 row_mask:0xf bank_mask:0x2
v_add_f32_dpp v112, v85, v112 quad_perm:[0,1,2,3] row_mask:0xf bank_mask:0x2
v_add_f32_dpp v112, v86, v112 row_ror:12 row_mask:0xf bank_mask:0x2
v_add_f32_dpp v112, v87, v112 row_ror:8 row_mask:0xf bank_mask:0x2
v_mov_b32_dpp v112, v88 row_ror:8 row_mask:0xf bank_mask:0x4
v_add_f32_dpp v112, v89, v112 row_ror:4 row_mask:0xf bank_mask:0x4
v_add_f32_dpp v112, v90, v112 quad_perm:[0,1,2,3] row_mask:0xf bank_mask:0x4
v_add_f32_dpp v112, v91, v112 row_ror:12 row_mask:0xf bank_mask:0x4
v_mov_b32_dpp v112, v92 row_ror:12 row_mask:0xf bank_mask:0x8
v_add_f32_dpp v112, v93, v112 row_ror:8 row_mask:0xf bank_mask:0x8
v_add_f32_dpp v112, v94, v112 row_ror:4 row_mask:0xf bank_mask:0x8
v_add_f32_dpp v112, v95, v112 quad_perm:[0,1,2,3] row_mask:0xf bank_mask:0x8
v_mov_b32_dpp v113, v96 quad_perm:[0,1,2,3] row_mask:0xf bank_mask:0x1
v_add_f32_dpp v113, v97, v113 row_ror:12 row_mask:0xf bank_mask:0x1
v_add_f32_dpp v113, v98, v113 row_ror:8 row_mask:0xf bank_mask:0x1
v_add_f32_dpp v113, v99, v113 row_ror:4 row_mask:0xf bank_mask:0x1
v_mov_b32_dpp v113, v100 row_ror:4 row_mask:0xf bank_mask:0x2
v_add_f32_dpp v113, v101, v113 quad_perm:[0,1,2,3] row_mask:0xf bank_mask:0x2
v_add_f32_dpp v113, v102, v113 row_ror:12 row_mask:0xf bank_mask:0x2
v_add_f32_dpp v113, v103, v113 row_ror:8 row_mask:0xf bank_mask:0x2
v_mov_b32_dpp v113, v104 row_ror:8 row_mask:0xf bank_mask:0x4
v_add_f32_dpp v113, v105, v113 row_ror:4 row_mask:0xf bank_mask:0x4
v_add_f32_dpp v113, v106, v113 quad_perm:[0,1,2,3] row_mask:0xf bank_mask:0x4
v_add_f32_dpp v113, v107, v113 row_ror:12 row_mask:0xf bank_mask:0x4
v_mov_b32_dpp v113, v108 row_ror:12 row_mask:0xf bank_mask:0x8
v_add_f32_dpp v113, v109, v113 row_ror:8 row_mask:0xf bank_mask:0x8
v_add_f32_dpp v113, v110, v113 row_ror:4 row_mask:0xf bank_mask:0x8
v_add_f32_dpp v113, v111, v113 quad_perm:[0,1,2,3] row_mask:0xf bank_mask:0x8
v_max_f32 v114, v112, v113
s_nop 1
v_max_f32_dpp v114, v114, v114 row_ror:4 row_mask:0xf bank_mask:0xf
s_nop 1
v_max_f32_dpp v114, v114, v114 row_ror:8 row_mask:0xf bank_mask:0xf
v_mov_b32 v1, v114
s_nop 1
v_permlane16_swap_b32 v1, v114
v_max_f32 v114, v114, v1
v_mov_b32 v1, v114
s_nop 1
v_permlane32_swap_b32 v1, v114
v_max_f32 v114, v114, v1
v_mul_f32 v116, v114, v117
v_fma_f32 v112, v112, v117, -v116
v_fma_f32 v113, v113, v117, -v116
v_exp_f32 v112, v112
v_exp_f32 v113, v113
s_nop 0
v_cvt_pk_bf16_f32 v118, v112, 0
v_cvt_pk_bf16_f32 v120, 0, v112
v_cvt_pk_bf16_f32 v119, v113, 0
v_cvt_pk_bf16_f32 v121, 0, v113
v_add_f32 v115, v112, v113
s_nop 0
v_mov_b32_dpp v122, v118 quad_perm:[0,1,2,3] row_mask:0xf bank_mask:0x1
v_mov_b32_dpp v122, v120 row_ror:4 row_mask:0xf bank_mask:0x2
v_mov_b32_dpp v123, v118 row_ror:8 row_mask:0xf bank_mask:0x4
v_mov_b32_dpp v123, v120 row_ror:12 row_mask:0xf bank_mask:0x8
v_mov_b32_dpp v124, v118 row_ror:12 row_mask:0xf bank_mask:0x1
v_mov_b32_dpp v124, v120 quad_perm:[0,1,2,3] row_mask:0xf bank_mask:0x2
v_mov_b32_dpp v125, v118 row_ror:4 row_mask:0xf bank_mask:0x4
v_mov_b32_dpp v125, v120 row_ror:8 row_mask:0xf bank_mask:0x8
v_add_f32_dpp v115, v115, v115 row_ror:4 row_mask:0xf bank_mask:0xf
v_lshlrev_b32 v100, 4, v0
s_lshl_b32 s38, s3, 11
s_waitcnt vmcnt(9)
v_mfma_f32_16x16x16_bf16 v[8:11], v[40:41], v[122:123], 0
v_mfma_f32_16x16x16_bf16 v[12:15], v[42:43], v[122:123], 0
v_mov_b32_dpp v122, v118 row_ror:8 row_mask:0xf bank_mask:0x1
v_mov_b32_dpp v122, v120 row_ror:12 row_mask:0xf bank_mask:0x2
v_mov_b32_dpp v123, v118 quad_perm:[0,1,2,3] row_mask:0xf bank_mask:0x4
v_mov_b32_dpp v123, v120 row_ror:4 row_mask:0xf bank_mask:0x8
v_add_f32_dpp v115, v115, v115 row_ror:8 row_mask:0xf bank_mask:0xf
v_add_u32 v101, s38, v100
v_and_b32 v102, 3, v0
s_waitcnt vmcnt(8)
v_mfma_f32_16x16x16_bf16 v[8:11], v[44:45], v[124:125], v[8:11]
v_mfma_f32_16x16x16_bf16 v[12:15], v[46:47], v[124:125], v[12:15]
v_mov_b32_dpp v124, v118 row_ror:4 row_mask:0xf bank_mask:0x1
v_mov_b32_dpp v124, v120 row_ror:8 row_mask:0xf bank_mask:0x2
v_mov_b32_dpp v125, v118 row_ror:12 row_mask:0xf bank_mask:0x4
v_mov_b32_dpp v125, v120 quad_perm:[0,1,2,3] row_mask:0xf bank_mask:0x8
v_mov_b32 v1, v115
v_lshlrev_b32 v103, 14, v102
v_lshlrev_b32 v102, 5, v102
s_waitcnt vmcnt(7)
v_mfma_f32_16x16x16_bf16 v[8:11], v[48:49], v[122:123], v[8:11]
v_mfma_f32_16x16x16_bf16 v[12:15], v[50:51], v[122:123], v[12:15]
v_mov_b32_dpp v122, v119 quad_perm:[0,1,2,3] row_mask:0xf bank_mask:0x1
v_mov_b32_dpp v122, v121 row_ror:4 row_mask:0xf bank_mask:0x2
v_mov_b32_dpp v123, v119 row_ror:8 row_mask:0xf bank_mask:0x4
v_mov_b32_dpp v123, v121 row_ror:12 row_mask:0xf bank_mask:0x8
v_permlane16_swap_b32 v1, v115
v_lshrrev_b32 v104, 4, v0
v_lshl_add_u32 v103, v104, 11, v103
s_waitcnt vmcnt(4)
v_mfma_f32_16x16x16_bf16 v[8:11], v[52:53], v[124:125], v[8:11]
v_mfma_f32_16x16x16_bf16 v[12:15], v[54:55], v[124:125], v[12:15]
v_mov_b32_dpp v124, v119 row_ror:12 row_mask:0xf bank_mask:0x1
v_mov_b32_dpp v124, v121 quad_perm:[0,1,2,3] row_mask:0xf bank_mask:0x2
v_mov_b32_dpp v125, v119 row_ror:4 row_mask:0xf bank_mask:0x4
v_mov_b32_dpp v125, v121 row_ror:8 row_mask:0xf bank_mask:0x8
v_add_f32 v115, v115, v1
v_mov_b32 v1, v115
v_bfe_u32 v104, v0, 2, 2
v_lshl_add_u32 v103, v104, 8, v103
s_waitcnt vmcnt(3)
v_mfma_f32_16x16x16_bf16 v[8:11], v[56:57], v[122:123], v[8:11]
v_mfma_f32_16x16x16_bf16 v[12:15], v[58:59], v[122:123], v[12:15]
v_mov_b32_dpp v122, v119 row_ror:8 row_mask:0xf bank_mask:0x1
v_mov_b32_dpp v122, v121 row_ror:12 row_mask:0xf bank_mask:0x2
v_mov_b32_dpp v123, v119 quad_perm:[0,1,2,3] row_mask:0xf bank_mask:0x4
v_mov_b32_dpp v123, v121 row_ror:4 row_mask:0xf bank_mask:0x8
v_permlane32_swap_b32 v1, v115
s_waitcnt vmcnt(2)
v_mfma_f32_16x16x16_bf16 v[8:11], v[60:61], v[124:125], v[8:11]
v_mfma_f32_16x16x16_bf16 v[12:15], v[62:63], v[124:125], v[12:15]
v_mov_b32_dpp v124, v119 row_ror:4 row_mask:0xf bank_mask:0x1
v_mov_b32_dpp v124, v121 row_ror:8 row_mask:0xf bank_mask:0x2
v_mov_b32_dpp v125, v119 row_ror:12 row_mask:0xf bank_mask:0x4
v_mov_b32_dpp v125, v121 quad_perm:[0,1,2,3] row_mask:0xf bank_mask:0x8
v_add_f32 v115, v115, v1
s_waitcnt vmcnt(1)
v_mfma_f32_16x16x16_bf16 v[8:11], v[64:65], v[122:123], v[8:11]
v_mfma_f32_16x16x16_bf16 v[12:15], v[66:67], v[122:123], v[12:15]
s_nop 1
s_waitcnt vmcnt(0)
v_mfma_f32_16x16x16_bf16 v[8:11], v[68:69], v[124:125], v[8:11]
v_mfma_f32_16x16x16_bf16 v[12:15], v[70:71], v[124:125], v[12:15]
s_cbranch_execz L_dry0_out
s_lshl_b32 s38, s3, 2
v_add_u32 v4, s38, v102
ds_write_b32 v4, v116 offset:8192
ds_write_b32 v4, v115 offset:8208
s_lshl_b32 s37, s28, 16
s_lshl_b32 s39, s3, 13
s_add_u32 s37, s37, s39
s_bfe_u32 s39, s29, 0x10002
s_lshl_b32 s39, s39, 10
ds_write_b128 v101, v[8:11] offset:0
ds_write_b128 v101, v[12:15] offset:1024
s_add_u32 s37, s37, s39
s_and_b32 s39, s29, 3
s_lshl_b32 s39, s39, 6
s_add_u32 s37, s37, s39
s_lshr_b32 s39, s29, 3
s_lshl_b32 s39, s39, 4
s_add_u32 s37, s37, s39
s_add_u32 s37, s37, 524288
v_add_u32 v103, s37, v103
s_lshl_b32 s38, s3, 10
v_add_u32 v101, s38, v100
s_lshl_b32 s37, s2, 11
s_add_u32 s37, s37, 1572864
v_add_u32 v104, s37, v101
s_waitcnt lgkmcnt(0)
s_barrier
s_cmp_ge_u32 s3, 2
s_cbranch_scc1 L_att_skip
ds_read_b128 v[32:35], v102 offset:8192
ds_read_b128 v[36:39], v102 offset:8208
ds_read_b128 v[16:19], v101 offset:0
ds_read_b128 v[20:23], v101 offset:2048
ds_read_b128 v[24:27], v101 offset:4096
ds_read_b128 v[28:31], v101 offset:6144
s_waitcnt lgkmcnt(4)
L_dry1_in:
v_max3_f32 v40, v32, v33, v34
v_max_f32 v40, v40, v35
v_sub_f32 v44, v32, v40
v_sub_f32 v45, v33, v40
v_sub_f32 v46, v34, v40
v_sub_f32 v47, v35, v40
v_exp_f32 v44, v44
v_exp_f32 v45, v45
v_exp_f32 v46, v46
v_exp_f32 v47, v47
v_mov_b32 v59, s31
v_mul_f32 v48, v44, v36
v_fmac_f32 v48, v45, v37
v_fmac_f32 v48, v46, v38
v_fmac_f32 v48, v47, v39
v_rcp_f32 v49, v48
v_log_f32 v50, v48
s_waitcnt lgkmcnt(0)
v_mul_f32 v44, v44, v49
v_mul_f32 v45, v45, v49
v_mul_f32 v46, v46, v49
v_mul_f32 v47, v47, v49
v_add_f32 v58, v40, v50
v_mul_f32 v52, v44, v16
v_mul_f32 v53, v44, v17
v_mul_f32 v54, v44, v18
v_mul_f32 v55, v44, v19
v_fmac_f32 v52, v45, v20
v_fmac_f32 v53, v45, v21
v_fmac_f32 v54, v45, v22
v_fmac_f32 v55, v45, v23
v_fmac_f32 v52, v46, v24
v_fmac_f32 v53, v46, v25
v_fmac_f32 v54, v46, v26
v_fmac_f32 v55, v46, v27
v_fmac_f32 v52, v47, v28
v_fmac_f32 v53, v47, v29
v_fmac_f32 v54, v47, v30
v_fmac_f32 v55, v47, v31
v_cvt_pk_bf16_f32 v56, v52, v53
v_cvt_pk_bf16_f32 v57, v54, v55
s_cbranch_execz L_dry1_out
global_store_dwordx4 v103, v[56:59], s[26:27]
global_store_dwordx4 v104, v[56:59], s[26:27] sc1
L_att_skip:
s_cmp_ge_u32 s3, 1
s_cbranch_scc1 L_d_none
s_cmp_ge_u32 s2, 128
s_cbranch_scc1 L_d_none
s_and_b32 s36, s2, 7
s_lshr_b32 s37, s2, 3
s_lshl_b32 s38, s36, 10
s_lshl_b32 s39, s37, 6
s_add_u32 s38, s38, s39
s_add_u32 s38, s38, 2621440
s_add_u32 s40, s26, s38
s_addc_u32 s41, s27, 0
v_lshrrev_b32 v1, 2, v0
v_lshlrev_b32 v1, 13, v1
v_and_b32 v2, 3, v0
v_lshl_add_u32 v1, v2, 4, v1
s_lshr_b32 s38, s36, 1
s_lshl_b32 s38, s38, 7
s_lshr_b32 s39, s37, 2
s_lshl_b32 s39, s39, 5
s_add_u32 s38, s38, s39
s_and_b32 s39, s36, 1
s_lshl_b32 s39, s39, 2
s_add_u32 s38, s38, s39
s_and_b32 s39, s37, 3
s_add_u32 s38, s38, s39
v_lshrrev_b32 v3, 4, v0
v_lshlrev_b32 v3, 3, v3
v_lshl_add_u32 v3, v2, 9, v3
v_add_u32 v3, s38, v3
v_lshlrev_b32 v3, 1, v3
global_load_ushort v24, v3, s[4:5]
s_mov_b32 s56, 0
s_barrier
global_load_dwordx4 v[8:11], v1, s[40:41] sc1
v_add_u32 v4, 131072, v1
global_load_dwordx4 v[12:15], v4, s[40:41] sc1
v_add_u32 v4, 262144, v1
global_load_dwordx4 v[16:19], v4, s[40:41] sc1
v_add_u32 v4, 393216, v1
global_load_dwordx4 v[20:23], v4, s[40:41] sc1
s_waitcnt vmcnt(0)
L_d_chk:
v_xor_b32 v8, s32, v8
v_xor_b32 v9, s33, v9
v_xor_b32 v10, s34, v10
v_xor_b32 v11, s35, v11
v_xor_b32 v12, s32, v12
v_xor_b32 v13, s33, v13
v_xor_b32 v14, s34, v14
v_xor_b32 v15, s35, v15
v_xor_b32 v16, s32, v16
v_xor_b32 v17, s33, v17
v_xor_b32 v18, s34, v18
v_xor_b32 v19, s35, v19
v_xor_b32 v20, s32, v20
v_xor_b32 v21, s33, v21
v_xor_b32 v22, s34, v22
v_xor_b32 v23, s35, v23
v_or3_b32 v2, v8, v9, v10
v_or3_b32 v2, v2, v11, v12
v_or3_b32 v2, v2, v13, v14
v_or3_b32 v2, v2, v15, v16
v_or3_b32 v2, v2, v17, v18
v_or3_b32 v2, v2, v19, v20
v_or3_b32 v2, v2, v21, v22
v_or_b32 v2, v2, v23
v_and_b32 v2, 0xff, v2
v_cmp_ne_u32 vcc, 0, v2
s_cbranch_vccz L_d_ok
s_add_u32 s56, s56, 1
s_cmp_gt_u32 s56, 60000
s_cbranch_scc1 L_d_ok
global_load_dwordx4 v[8:11], v1, s[40:41] sc1
v_add_u32 v4, 131072, v1
global_load_dwordx4 v[12:15], v4, s[40:41] sc1
v_add_u32 v4, 262144, v1
global_load_dwordx4 v[16:19], v4, s[40:41] sc1
v_add_u32 v4, 393216, v1
global_load_dwordx4 v[20:23], v4, s[40:41] sc1
s_waitcnt vmcnt(0)
s_branch L_d_chk
L_d_ok:
L_dry4_in:
v_add_f32 v8, v8, v12
v_add_f32 v16, v16, v20
v_add_f32 v9, v9, v13
v_add_f32 v17, v17, v21
v_add_f32 v10, v10, v14
v_add_f32 v18, v18, v22
v_add_f32 v11, v11, v15
v_add_f32 v19, v19, v23
v_add_f32 v8, v8, v16
v_add_f32 v9, v9, v17
v_add_f32 v10, v10, v18
v_add_f32 v11, v11, v19
v_add_f32_dpp v8, v8, v8 row_ror:4 row_mask:0xf bank_mask:0xf
v_add_f32_dpp v9, v9, v9 row_ror:4 row_mask:0xf bank_mask:0xf
v_add_f32_dpp v10, v10, v10 row_ror:4 row_mask:0xf bank_mask:0xf
v_add_f32_dpp v11, v11, v11 row_ror:4 row_mask:0xf bank_mask:0xf
v_add_f32_dpp v8, v8, v8 row_ror:8 row_mask:0xf bank_mask:0xf
v_add_f32_dpp v9, v9, v9 row_ror:8 row_mask:0xf bank_mask:0xf
v_add_f32_dpp v10, v10, v10 row_ror:8 row_mask:0xf bank_mask:0xf
v_add_f32_dpp v11, v11, v11 row_ror:8 row_mask:0xf bank_mask:0xf
s_nop 0
v_permlane32_swap_b32 v8, v10
v_permlane32_swap_b32 v9, v11
v_add_f32 v8, v8, v10
v_add_f32 v9, v9, v11
v_lshlrev_b32 v24, 16, v24
s_nop 0
v_permlane16_swap_b32 v8, v9
v_add_f32 v8, v8, v9
v_add_f32 v8, v8, v24
v_cvt_pk_bf16_f32 v8, v8, v8
s_cbranch_execz L_dry4_out
s_mov_b32 exec_lo, 0x000f000f
s_mov_b32 exec_hi, 0x000f000f
global_store_short v3, v8, s[22:23]
s_or_b32 s38, s2, s3
s_cmp_lg_u32 s38, 0
s_cbranch_scc1 L_fin
s_add_u32 s38, s30, 1
v_mov_b32 v2, s38
v_mov_b32 v4, 0
global_store_dword v4, v2, s[26:27]
s_branch L_fin
L_d_none:
s_barrier
s_branch L_fin
L_fin:
L_end:
s_endpgm
L_code_end:
.section .rodata,"a"
.p2align 6
.amdhsa_kernel parallel_sum__sliding_block_cached__glu_gated_geglu__decode_kernel
  .amdhsa_next_free_vgpr 128
  .amdhsa_next_free_sgpr 72
  .amdhsa_accum_offset 128
  .amdhsa_group_segment_fixed_size 0
  .amdhsa_kernarg_size 96
  .amdhsa_user_sgpr_count 2
  .amdhsa_user_sgpr_kernarg_segment_ptr 1
  .amdhsa_system_sgpr_workgroup_id_x 1
  .amdhsa_float_denorm_mode_32 3
.end_amdhsa_kernel
```
